```python
import torch

def _softmax(x, axis=-1):
    return torch.softmax(x, dim=axis)
def _gelu(x):
    return torch.nn.functional.gelu(x, approximate="tanh")
def _silu(x):
    return torch.nn.functional.silu(x)
def _sigmoid(x):
    return torch.sigmoid(x)
def _layernorm(x, axis=-1, eps=1e-5):
    m = x.mean(dim=axis, keepdim=True)
    v = x.var(dim=axis, keepdim=True, unbiased=False)
    return (x - m) / torch.sqrt(v + eps)
def _scatter_add(tgt, idx, src, axis=0):
    return tgt.clone().index_add_(axis, idx, src)
def _segment_sum(src, seg, n):
    out = torch.zeros((n,) + src.shape[1:], dtype=src.dtype)
    return out.index_add_(0, seg, src)
def _pad(x, pw):
    flat = tuple(v for pair in reversed(pw) for v in pair)
    return torch.nn.functional.pad(x, flat)

kernel_name = 'gated_mix__sliding_block_cached__glu_gated_geglu__decode'

def setup_inputs():

    _w = (lambda a: (lambda t: t.to(torch.bfloat16) if t.is_floating_point() else t)(torch.as_tensor(a)))
    def _A_setup():
        B, Sq, D = 4, 1, 640
        Hq, Hkv, Sk, Dh = 32, 32, 4096, 128
        assert Hq % Hkv == 0, (Hq, Hkv)
        return {
            "x": _w((lambda *s: torch.randn(*s, dtype=torch.bfloat16) * 0.05)(B, Sq, D)),
            "k_cache": _w((lambda *s: torch.randn(*s, dtype=torch.bfloat16) * 6.4)(B, Hkv, Sk, Dh)),
            "v_cache": _w((lambda *s: torch.randn(*s, dtype=torch.bfloat16) * 0.05)(B, Hkv, Sk, Dh)),
            "wq": _w((lambda *s: torch.randn(*s, dtype=torch.bfloat16) * 6.4)(D, Hq * Dh) * (D ** -0.5)),
            "wo": _w((lambda *s: torch.randn(*s, dtype=torch.bfloat16) * 0.05)(Hq * Dh, D) * ((Hq * Dh) ** -0.5)),
        }
    _A_in = _A_setup()

    def _B_setup():
        B, S, Dm, Df = 4, 1, 640, 1728
        return {
            "x": _w((lambda *s: torch.randn(*s, dtype=torch.bfloat16) * 0.05)(B, S, Dm)),
            "w_gate": _w((lambda *s: torch.randn(*s, dtype=torch.bfloat16) * 0.8)(Dm, Df) * (Dm ** -0.5)),
            "w_up": _w((lambda *s: torch.randn(*s, dtype=torch.bfloat16) * 0.8)(Dm, Df) * (Dm ** -0.5)),
            "w_down": _w((lambda *s: torch.randn(*s, dtype=torch.bfloat16) * 0.8)(Df, Dm) * (Df ** -0.5)),
        }
    _B_in = _B_setup()

    return {
        "A_x": _A_in["x"],
        "A_k_cache": _A_in["k_cache"],
        "A_v_cache": _A_in["v_cache"],
        "A_wq": _A_in["wq"],
        "A_wo": _A_in["wo"],
        "B_x": _B_in["x"],
        "B_w_gate": _B_in["w_gate"],
        "B_w_up": _B_in["w_up"],
        "B_w_down": _B_in["w_down"],
        "gate_w": _w((lambda *s: torch.randn(*s, dtype=torch.bfloat16) * 0.05)(640) * 16.0),
    }

def reference(A_x, A_k_cache, A_v_cache, A_wq, A_wo, B_x, B_w_gate, B_w_up, B_w_down, gate_w):
    def _A_ref(x, k_cache, v_cache, wq, wo):
        B, Sq, D = x.shape
        Hq, Dh = 32, 128
        Hkv, Sk = k_cache.shape[1], k_cache.shape[2]
        W = min(4096, max(256, Sk // 4))
        rep = Hq // Hkv
        q = (lambda x, *d: x.permute(*d))((x @ wq).reshape(B, Sq, Hq, Dh), 0, 2, 1, 3)
        k = (lambda x, n, axis: torch.repeat_interleave(x, n, dim=axis))(k_cache[:, :, Sk - W:, :], rep, axis=1)
        v = (lambda x, n, axis: torch.repeat_interleave(x, n, dim=axis))(v_cache[:, :, Sk - W:, :], rep, axis=1)
        scores = torch.einsum("bhqd,bhkd->bhqk", q, k) * (Dh ** -0.5)
        p = _softmax(scores, axis=-1)
        o = torch.einsum("bhqk,bhkd->bhqd", p, v)
        return (lambda x, *d: x.permute(*d))(o, 0, 2, 1, 3).reshape(B, Sq, Hq * Dh) @ wo

    def _B_ref(x, w_gate, w_up, w_down):
        g = torch.einsum("bsd,df->bsf", x, w_gate)
        u = torch.einsum("bsd,df->bsf", x, w_up)
        h = _gelu(g) * u
        return torch.einsum("bsf,fd->bsd", h, w_down)

    x = A_x
    g = _sigmoid((x * gate_w).sum(-1, keepdims=True))
    a = _A_ref(x, A_k_cache, A_v_cache, A_wq, A_wo)
    b = _B_ref(x, B_w_gate, B_w_up, B_w_down)
    return g * a + (1 - g) * b
```

```asm
; @launch grid=(256,1,1) block=(1024,1,1) lds=50432
.amdgcn_target "amdgcn-amd-amdhsa--gfx950"
.text
.globl gated_mix__sliding_block_cached__glu_gated_geglu__decode_kernel
.p2align 8
.type gated_mix__sliding_block_cached__glu_gated_geglu__decode_kernel,@function
gated_mix__sliding_block_cached__glu_gated_geglu__decode_kernel:
  s_cmp_ge_u32 s2, 256
  s_cbranch_scc1 L_end
  s_load_dwordx16 s[16:31], s[0:1], 0
  s_load_dwordx8 s[32:39], s[0:1], 64
  s_load_dwordx2 s[40:41], s[0:1], 96
  v_lshrrev_b32 v1, 6, v0
  v_and_b32 v0, 63, v0
  v_readfirstlane_b32 s3, v1
  s_lshr_b32 s8, s2, 3
  s_lshr_b32 s9, s8, 3
  s_mul_i32 s4, s9, 3
  s_add_u32 s4, s4, s2
  s_and_b32 s4, s4, 7
  s_lshl_b32 s4, s4, 2
  s_add_u32 s4, s4, s9
  s_bfe_u32 s5, s8, 0x20001
  s_and_b32 s6, s8, 7
  s_lshl_b32 s7, s4, 3
  s_add_u32 s7, s7, s6
  s_mul_i32 s10, s4, 3
  s_add_u32 s10, s10, s6
  s_sub_u32 s10, s10, 5
  s_lshl_b32 s10, s10, 1
  s_cmp_ge_u32 s6, 5
  s_cselect_b32 s73, s10, 160
  s_cmp_ge_u32 s3, 8
  s_cbranch_scc1 L_S
  s_setprio 3
  s_memrealtime s[74:75]
  v_and_b32 v1, 15, v0
  v_lshrrev_b32 v2, 4, v0
  v_mov_b32 v3, 0
  s_lshl_b32 s9, s9, 3
  s_and_b32 s10, s2, 7
  s_add_u32 s9, s9, s10
  s_and_b32 s12, s6, 3
  s_cmp_lt_u32 s6, 4
  s_movk_i32 s10, 3456
  s_cselect_b32 s10, 8192, s10
  s_cbranch_scc0 L_dec_ffn
  s_lshl_b32 s13, s4, 2
  s_add_u32 s13, s13, s12
  s_lshl_b32 s11, s4, 8
  s_add_u32 s14, s11, 128
  s_mov_b32 s100, 1
  s_branch L_dec_done
L_dec_ffn:
  s_lshl_b32 s11, s9, 7
  s_mov_b32 s14, s11
  s_lshl_b32 s13, s9, 2
  s_add_u32 s13, s13, s12
  s_add_u32 s13, s13, 128
  s_cmp_lt_u32 s9, 27
  s_cselect_b32 s100, 1, 0
L_dec_done:
  s_mov_b32 s99, s9
  s_mul_i32 s12, s12, 160
  s_mul_i32 s15, s3, 20
  s_add_u32 s12, s12, s15
  s_mul_i32 s15, s12, s10
  s_add_u32 s11, s11, s15
  s_add_u32 s14, s14, s15
  s_lshl_b32 s12, s12, 1
  s_lshl_b32 s15, s10, 1
  v_lshrrev_b32 v6, 5, v0
  v_mul_u32_u24 v7, 10, v6
  v_and_b32 v5, 1, v2
  v_add_u32 v7, v7, v5
  v_and_b32 v4, 7, v0
  v_lshlrev_b32 v4, 4, v4
  v_mad_u32_u24 v4, v7, s10, v4
  v_lshrrev_b32 v5, 2, v1
  v_mul_u32_u24 v5, 1280, v5
  v_mul_u32_u24 v6, 20, v6
  v_add_u32 v5, v5, v6
  s_waitcnt lgkmcnt(0)
  s_mov_b32 s68, s38
  s_and_b32 s69, s39, 0xffff
  s_mov_b32 s70, 256
  s_mov_b32 s71, 0x20000
  s_or_b32 s9, s2, s3
  s_cmp_lg_u32 s9, 0
  s_cbranch_scc1 L_nonon
  s_or_b32 s75, s75, 0x80000000
  v_mov_b32 v12, s74
  v_mov_b32 v13, s75
  v_mov_b32 v14, 0
  v_mov_b32 v15, 0
  s_mov_b64 exec, 1
  buffer_atomic_cmpswap_x2 v[12:15], v3, s[68:71], 0 offen sc1
  s_mov_b64 exec, -1
L_nonon:
  s_mov_b32 s56, s16
  s_and_b32 s57, s17, 0xffff
  s_mov_b32 s58, 5120
  s_mov_b32 s59, 0x20000
  s_cmp_eq_u32 s100, 0
  s_cbranch_scc1 L_nos1load
  buffer_load_dwordx4 v[72:75], v5, s[56:59], s12 offen
  buffer_load_dword v76, v5, s[56:59], s12 offen offset:16
  s_cmp_lt_u32 s6, 4
  s_cselect_b32 s48, s22, s28
  s_cselect_b32 s49, s23, s29
  s_cselect_b32 s52, s22, s30
  s_cselect_b32 s53, s23, s31
  s_add_u32 s48, s48, s11
  s_addc_u32 s49, s49, 0
  s_add_u32 s52, s52, s14
  s_addc_u32 s53, s53, 0
  v_cmp_gt_u32 vcc, 8, v1
  v_mov_b32 v6, s52
  v_mov_b32 v7, s53
  v_mov_b32 v8, s48
  v_mov_b32 v9, s49
  v_cndmask_b32 v6, v6, v8, vcc
  v_cndmask_b32 v7, v7, v9, vcc
  v_add_co_u32 v6, vcc, v6, v4
  s_nop 1
  v_addc_co_u32 v7, vcc, 0, v7, vcc
  global_load_dwordx4 v[28:31], v[6:7], off nt
  v_add_co_u32 v6, vcc, s15, v6
  s_nop 1
  v_addc_co_u32 v7, vcc, 0, v7, vcc
  global_load_dwordx4 v[32:35], v[6:7], off nt
  v_add_co_u32 v6, vcc, s15, v6
  s_nop 1
  v_addc_co_u32 v7, vcc, 0, v7, vcc
  global_load_dwordx4 v[36:39], v[6:7], off nt
  v_add_co_u32 v6, vcc, s15, v6
  s_nop 1
  v_addc_co_u32 v7, vcc, 0, v7, vcc
  global_load_dwordx4 v[40:43], v[6:7], off nt
  v_add_co_u32 v6, vcc, s15, v6
  s_nop 1
  v_addc_co_u32 v7, vcc, 0, v7, vcc
  global_load_dwordx4 v[44:47], v[6:7], off nt
L_nos1load:
  s_cmp_lg_u32 s3, 2
  s_cbranch_scc1 L_nonp
  buffer_load_dwordx2 v[78:79], v3, s[68:71], 0 offen sc1
L_nonp:
  s_cmp_lg_u32 s3, 1
  s_cbranch_scc1 L_noinit
  v_mov_b32 v8, 0
  v_mov_b32 v9, 0
  v_mov_b32 v10, 0
  v_mov_b32 v11, 0
  v_lshlrev_b32 v6, 4, v0
  ds_write_b128 v6, v[8:11]
  s_waitcnt lgkmcnt(0)
L_noinit:
  s_barrier
  s_mov_b32 s52, s99
  s_mov_b32 s53, s100
  s_mov_b32 s44, s40
  s_and_b32 s45, s41, 0xffff
  s_mov_b32 s46, 4194304
  s_mov_b32 s47, 0x20000
  s_getreg_b32 s51, hwreg(HW_REG_XCC_ID, 0, 4)
  v_and_b32 v7, 1, v0
  v_lshlrev_b32 v7, 4, v7
  v_mov_b32 v6, 0x0c0c0000
  v_lshrrev_b32 v6, v7, v6
  v_mov_b32 v64, 0x0100
  v_mov_b32 v66, 0x0302
  v_lshlrev_b32 v64, v7, v64
  v_lshlrev_b32 v66, v7, v66
  v_or_b32 v64, v64, v6
  v_or_b32 v66, v66, v6
  v_mov_b32 v6, 0x0c0c0c0c
  v_and_b32 v7, 2, v0
  v_cmp_eq_u32 vcc, 0, v7
  s_nop 1
  v_cndmask_b32 v65, v64, v6, vcc
  v_cndmask_b32 v67, v66, v6, vcc
  v_cndmask_b32 v64, v6, v64, vcc
  v_cndmask_b32 v66, v6, v66, vcc
  v_and_b32 v7, 1, v2
  v_cmp_eq_u32 vcc, 1, v7
  s_nop 1
  v_cndmask_b32 v6, v64, v66, vcc
  v_cndmask_b32 v7, v65, v67, vcc
  s_cmp_lt_u32 s6, 5
  s_cselect_b32 s60, s24, s32
  s_cselect_b32 s61, s25, s33
  s_mov_b32 s62, 2211840
  s_cselect_b32 s62, 5242880, s62
  s_mov_b32 s63, 0x20000
  s_and_b32 s61, s61, 0xffff
  v_lshlrev_b32 v4, 5, v1
  v_lshl_add_u32 v4, v2, 9, v4
  s_waitcnt vmcnt(0)
  s_cmp_eq_u32 s53, 0
  s_cbranch_scc1 L_nos1
  v_perm_b32 v80, v72, v72, v6
  v_perm_b32 v81, v72, v72, v7
  v_perm_b32 v82, v73, v73, v6
  v_perm_b32 v83, v73, v73, v7
  v_perm_b32 v84, v74, v74, v6
  v_perm_b32 v85, v74, v74, v7
  v_perm_b32 v86, v75, v75, v6
  v_perm_b32 v87, v75, v75, v7
  v_perm_b32 v88, v76, v76, v6
  v_perm_b32 v89, v76, v76, v7
  v_mfma_f32_16x16x16_bf16 v[8:11], v[80:81], v[28:29], 0
  v_mfma_f32_16x16x16_bf16 v[12:15], v[80:81], v[30:31], 0
  v_mfma_f32_16x16x16_bf16 v[8:11], v[82:83], v[32:33], v[8:11]
  v_mfma_f32_16x16x16_bf16 v[12:15], v[82:83], v[34:35], v[12:15]
  v_mfma_f32_16x16x16_bf16 v[8:11], v[84:85], v[36:37], v[8:11]
  v_mfma_f32_16x16x16_bf16 v[12:15], v[84:85], v[38:39], v[12:15]
  v_mfma_f32_16x16x16_bf16 v[8:11], v[86:87], v[40:41], v[8:11]
  v_mfma_f32_16x16x16_bf16 v[12:15], v[86:87], v[42:43], v[12:15]
  v_mfma_f32_16x16x16_bf16 v[8:11], v[88:89], v[44:45], v[8:11]
  v_mfma_f32_16x16x16_bf16 v[12:15], v[88:89], v[46:47], v[12:15]
  s_lshl_b32 s9, s3, 11
  v_add_u32 v6, s9, v4
  s_nop 4
  ds_write_b128 v6, v[8:11] offset:1024
  ds_write_b128 v6, v[12:15] offset:1040
  s_mov_b64 exec, 1
  v_mov_b32 v7, 1
  ds_add_u32 v3, v7 offset:0
  s_mov_b64 exec, -1
L_nos1:
  s_nop 9
  s_cmp_eq_u32 s3, 2
  s_cbranch_scc1 L_role_q
  s_cmp_eq_u32 s3, 4
  s_cbranch_scc1 L_role_g
  s_mov_b32 s42, 0x40000
LW_1:
  ds_read_b32 v72, v3 offset:4
  s_waitcnt lgkmcnt(0)
  v_readfirstlane_b32 s43, v72
  s_nop 1
  s_cmp_lt_u32 s43, 1
  s_cbranch_scc1 LR_3
LWD_2:
  ds_read_b64 v[72:73], v3 offset:40
  s_waitcnt lgkmcnt(0)
  v_readfirstlane_b32 s76, v72
  v_readfirstlane_b32 s77, v73
  s_cmp_eq_u32 s3, 3
  s_cbranch_scc1 L_role_s
  s_cmp_eq_u32 s3, 5
  s_cbranch_scc1 L_roles_done
  s_cmp_eq_u32 s53, 0
  s_cbranch_scc1 L_roles_done
  s_and_b32 s9, s3, 3
  s_lshl_b32 s10, s9, 9
  v_lshl_add_u32 v6, v0, 3, s10
  v_lshlrev_b32 v124, 1, v6
  s_cmp_lt_u32 s6, 4
  s_cbranch_scc1 L_pubq
  v_bfe_u32 v6, v0, 3, 2
  v_lshlrev_b32 v6, 9, v6
  v_bfe_u32 v72, v0, 2, 1
  v_lshl_add_u32 v6, v72, 8, v6
  v_lshrrev_b32 v72, 5, v0
  v_lshl_add_u32 v6, v72, 5, v6
  v_and_b32 v72, 3, v0
  v_lshl_add_u32 v6, v72, 3, v6
  s_lshl_b32 s10, s9, 6
  v_add_u32 v6, s10, v6
L_pubq:
  s_lshl_b32 s55, s13, 12
  s_mov_b32 s42, 0x40000
LW_4:
  ds_read_b32 v72, v3 offset:0
  s_waitcnt lgkmcnt(0)
  v_readfirstlane_b32 s43, v72
  s_nop 1
  s_cmp_lt_u32 s43, 8
  s_cbranch_scc1 LR_6
LWD_5:
  ds_read_b64 v[120:121], v6 offset:1024
  ds_read_b64 v[76:77], v6 offset:3072
  ds_read_b64 v[78:79], v6 offset:5120
  ds_read_b64 v[80:81], v6 offset:7168
  ds_read_b64 v[82:83], v6 offset:9216
  ds_read_b64 v[84:85], v6 offset:11264
  ds_read_b64 v[86:87], v6 offset:13312
  ds_read_b64 v[88:89], v6 offset:15360
  v_mov_b32 v122, s76
  v_mov_b32 v123, s77
  s_waitcnt lgkmcnt(4)
  v_pk_add_f32 v[120:121], v[120:121], v[76:77]
  v_pk_add_f32 v[78:79], v[78:79], v[80:81]
  s_waitcnt lgkmcnt(0)
  v_pk_add_f32 v[82:83], v[82:83], v[84:85]
  v_pk_add_f32 v[86:87], v[86:87], v[88:89]
  v_pk_add_f32 v[120:121], v[120:121], v[78:79]
  v_pk_add_f32 v[82:83], v[82:83], v[86:87]
  v_pk_add_f32 v[120:121], v[120:121], v[82:83]
  buffer_store_dwordx4 v[120:123], v124, s[44:47], s55 offen
  s_nop 1
  s_mov_b32 s42, 0x40000
LW_7:
  ds_read_b32 v72, v3 offset:12
  s_waitcnt lgkmcnt(0)
  v_readfirstlane_b32 s43, v72
  s_nop 1
  s_cmp_lt_u32 s43, 1
  s_cbranch_scc1 LR_9
LWD_8:
  s_cmp_eq_u32 s43, 2
  s_cbranch_scc1 L_roles_done
  buffer_store_dwordx4 v[120:123], v124, s[44:47], s55 offen sc1
  s_branch L_roles_done
L_role_q:
  s_nop 1
  s_mov_b32 s42, 20000
FL_10:
  v_readfirstlane_b32 s77, v79
  v_readfirstlane_b32 s76, v78
  s_nop 0
  s_cmp_lg_u32 s77, 0
  s_cbranch_scc1 FLD_11
  buffer_load_dwordx2 v[78:79], v3, s[68:71], 0 offen sc1
  s_sub_u32 s42, s42, 1
  s_cmp_lg_u32 s42, 0
  s_waitcnt vmcnt(0)
  s_cbranch_scc1 FL_10
FLD_11:
  v_mov_b32 v76, s51
  v_mov_b32 v77, 0
  s_lshl_b32 s9, s7, 4
  s_add_u32 s9, s9, 3149824
  s_mov_b64 exec, 1
  ds_write_b64 v3, v[78:79] offset:40
  v_mov_b32 v7, 1
  ds_write_b32 v3, v7 offset:4
  buffer_store_dwordx4 v[76:79], v3, s[44:47], s9 offen
  s_mov_b64 exec, -1
  v_lshlrev_b32 v6, 4, v0
  v_and_b32 v7, 0x70, v6
  s_lshl_b32 s9, s4, 7
  s_add_u32 s9, s9, 3149824
  s_mov_b32 s42, 4
HL_12:
  buffer_load_dwordx4 v[44:47], v7, s[44:47], s9 offen sc1
  s_waitcnt vmcnt(0)
  v_cmp_ne_u64 vcc, s[76:77], v[46:47]
  v_cmp_ne_u32 s[78:79], s51, v44
  s_nop 1
  s_or_b64 vcc, vcc, s[78:79]
  s_cselect_b32 s10, 1, 2
  s_cbranch_scc0 HD_13
  s_sub_u32 s42, s42, 1
  s_cmp_lg_u32 s42, 0
  s_cbranch_scc1 HL_12
HD_13:
  v_mov_b32 v7, s10
  s_mov_b64 exec, 1
  ds_write_b32 v3, v7 offset:12
  s_mov_b64 exec, -1
  s_lshl_b32 s9, s4, 14
  s_lshl_b32 s10, s5, 10
  s_add_u32 s9, s9, s10
  s_add_u32 s10, s9, 4096
  s_add_u32 s11, s9, 8192
  s_add_u32 s12, s9, 12288
  s_mov_b32 s42, 20000
  s_mov_b64 s[92:93], -1
  s_mov_b64 s[94:95], -1
  s_mov_b64 s[96:97], -1
  s_mov_b64 s[98:99], -1
G_14:
  s_mov_b64 exec, s[92:93]
  buffer_load_dwordx4 v[28:31], v6, s[44:47], s9 offen sc1
  s_mov_b64 exec, s[94:95]
  buffer_load_dwordx4 v[32:35], v6, s[44:47], s10 offen sc1
  s_mov_b64 exec, s[96:97]
  buffer_load_dwordx4 v[36:39], v6, s[44:47], s11 offen sc1
  s_mov_b64 exec, s[98:99]
  buffer_load_dwordx4 v[40:43], v6, s[44:47], s12 offen sc1
  s_waitcnt vmcnt(0)
GC_16:
  s_mov_b64 exec, s[92:93]
  v_cmp_ne_u64 s[92:93], s[76:77], v[30:31]
  s_mov_b64 exec, s[94:95]
  v_cmp_ne_u64 s[94:95], s[76:77], v[34:35]
  s_mov_b64 exec, s[96:97]
  v_cmp_ne_u64 s[96:97], s[76:77], v[38:39]
  s_mov_b64 exec, s[98:99]
  v_cmp_ne_u64 s[98:99], s[76:77], v[42:43]
  s_mov_b64 exec, -1
  s_or_b64 s[78:79], s[92:93], s[94:95]
  s_or_b64 s[78:79], s[78:79], s[96:97]
  s_or_b64 s[78:79], s[78:79], s[98:99]
  s_cbranch_scc1 GR_17
GD_15:
  v_pk_add_f32 v[28:29], v[28:29], v[32:33]
  v_pk_add_f32 v[36:37], v[36:37], v[40:41]
  v_pk_add_f32 v[28:29], v[28:29], v[36:37]
  v_cvt_pk_bf16_f32 v28, v28, v29
  v_lshlrev_b32 v6, 2, v0
  ds_write_b32 v6, v28 offset:50176
  s_mov_b64 exec, 1
  v_mov_b32 v7, 1
  ds_write_b32 v3, v7 offset:8
  s_mov_b64 exec, -1
  s_branch L_roles_done
L_role_s:
  s_nop 1
  v_and_b32 v42, 7, v0
  v_lshlrev_b32 v42, 2, v42
  s_lshl_b32 s9, s7, 4
  s_add_u32 s9, s9, 3145728
  v_mov_b32 v30, s76
  v_mov_b32 v31, s77
  s_mov_b32 s42, 0x40000
LW_18:
  ds_read_b32 v72, v3 offset:16
  s_waitcnt lgkmcnt(0)
  v_readfirstlane_b32 s43, v72
  s_nop 1
  s_cmp_lt_u32 s43, 8
  s_cbranch_scc1 LR_20
LWD_19:
  ds_read_b32 v36, v42 offset:64
  ds_read_b32 v37, v42 offset:96
  ds_read_b32 v72, v3 offset:12
  s_waitcnt lgkmcnt(0)
  v_readfirstlane_b32 s10, v72
  v_mov_b32 v28, v36
  s_nop 1
  v_max_f32_dpp v28, v28, v28 row_ror:1 row_mask:0xf bank_mask:0xf
  s_nop 1
  v_max_f32_dpp v28, v28, v28 row_ror:2 row_mask:0xf bank_mask:0xf
  s_nop 1
  v_max_f32_dpp v28, v28, v28 row_ror:4 row_mask:0xf bank_mask:0xf
  v_sub_f32 v41, v36, v28
  v_exp_f32 v41, v41
  s_nop 0
  v_mul_f32 v29, v41, v37
  s_nop 1
  v_add_f32_dpp v29, v29, v29 row_ror:1 row_mask:0xf bank_mask:0xf
  s_nop 1
  v_add_f32_dpp v29, v29, v29 row_ror:2 row_mask:0xf bank_mask:0xf
  s_nop 1
  v_add_f32_dpp v29, v29, v29 row_ror:4 row_mask:0xf bank_mask:0xf
  v_and_b32 v29, -16, v29
  v_or_b32 v29, s51, v29
  s_mov_b64 exec, 1
  s_cmp_eq_u32 s10, 2
  s_cbranch_scc1 L_stl
  buffer_store_dwordx4 v[28:31], v3, s[44:47], s9 offen sc1
  s_branch L_std
L_stl:
  buffer_store_dwordx4 v[28:31], v3, s[44:47], s9 offen
L_std:
  s_mov_b64 exec, -1
  s_branch L_roles_done
L_role_g:
  s_nop 1
  s_cmp_ge_u32 s73, 160
  s_cbranch_scc1 L_nogate
  s_mov_b32 s64, s34
  s_and_b32 s65, s35, 0xffff
  s_mov_b32 s66, 1280
  s_mov_b32 s67, 0x20000
  s_bfe_u32 s11, s73, 0x20003
  s_mul_i32 s14, s11, 1280
  v_lshlrev_b32 v6, 2, v0
  buffer_load_dword v28, v6, s[56:59], s14 offen offset:0
  buffer_load_dword v29, v6, s[56:59], s14 offen offset:256
  buffer_load_dword v30, v6, s[56:59], s14 offen offset:512
  buffer_load_dword v31, v6, s[56:59], s14 offen offset:768
  buffer_load_dword v32, v6, s[56:59], s14 offen offset:1024
  buffer_load_dword v36, v6, s[64:67], 0 offen offset:0
  buffer_load_dword v37, v6, s[64:67], 0 offen offset:256
  buffer_load_dword v38, v6, s[64:67], 0 offen offset:512
  buffer_load_dword v39, v6, s[64:67], 0 offen offset:768
  buffer_load_dword v40, v6, s[64:67], 0 offen offset:1024
  v_mov_b32 v72, 0
  s_waitcnt vmcnt(0)
  v_lshlrev_b32 v73, 16, v28
  v_lshlrev_b32 v74, 16, v36
  v_and_b32 v75, 0xffff0000, v28
  v_and_b32 v76, 0xffff0000, v36
  v_mul_f32 v73, v73, v74
  v_mul_f32 v75, v75, v76
  v_cvt_pk_bf16_f32 v73, v73, v75
  v_lshlrev_b32 v74, 16, v73
  v_and_b32 v75, 0xffff0000, v73
  v_add_f32 v72, v72, v74
  v_add_f32 v72, v72, v75
  v_lshlrev_b32 v73, 16, v29
  v_lshlrev_b32 v74, 16, v37
  v_and_b32 v75, 0xffff0000, v29
  v_and_b32 v76, 0xffff0000, v37
  v_mul_f32 v73, v73, v74
  v_mul_f32 v75, v75, v76
  v_cvt_pk_bf16_f32 v73, v73, v75
  v_lshlrev_b32 v74, 16, v73
  v_and_b32 v75, 0xffff0000, v73
  v_add_f32 v72, v72, v74
  v_add_f32 v72, v72, v75
  v_lshlrev_b32 v73, 16, v30
  v_lshlrev_b32 v74, 16, v38
  v_and_b32 v75, 0xffff0000, v30
  v_and_b32 v76, 0xffff0000, v38
  v_mul_f32 v73, v73, v74
  v_mul_f32 v75, v75, v76
  v_cvt_pk_bf16_f32 v73, v73, v75
  v_lshlrev_b32 v74, 16, v73
  v_and_b32 v75, 0xffff0000, v73
  v_add_f32 v72, v72, v74
  v_add_f32 v72, v72, v75
  v_lshlrev_b32 v73, 16, v31
  v_lshlrev_b32 v74, 16, v39
  v_and_b32 v75, 0xffff0000, v31
  v_and_b32 v76, 0xffff0000, v39
  v_mul_f32 v73, v73, v74
  v_mul_f32 v75, v75, v76
  v_cvt_pk_bf16_f32 v73, v73, v75
  v_lshlrev_b32 v74, 16, v73
  v_and_b32 v75, 0xffff0000, v73
  v_add_f32 v72, v72, v74
  v_add_f32 v72, v72, v75
  v_lshlrev_b32 v73, 16, v32
  v_lshlrev_b32 v74, 16, v40
  v_and_b32 v75, 0xffff0000, v32
  v_and_b32 v76, 0xffff0000, v40
  v_mul_f32 v73, v73, v74
  v_mul_f32 v75, v75, v76
  v_cvt_pk_bf16_f32 v73, v73, v75
  v_lshlrev_b32 v74, 16, v73
  v_and_b32 v75, 0xffff0000, v73
  v_add_f32 v72, v72, v74
  v_add_f32 v72, v72, v75
  s_nop 1
  v_add_f32_dpp v72, v72, v72 row_ror:1 row_mask:0xf bank_mask:0xf
  s_nop 1
  v_add_f32_dpp v72, v72, v72 row_ror:2 row_mask:0xf bank_mask:0xf
  s_nop 1
  v_add_f32_dpp v72, v72, v72 row_ror:4 row_mask:0xf bank_mask:0xf
  s_nop 1
  v_add_f32_dpp v72, v72, v72 row_ror:8 row_mask:0xf bank_mask:0xf
  v_mov_b32 v73, v72
  s_nop 1
  v_permlane16_swap_b32 v72, v73
  v_add_f32 v72, v72, v73
  v_mov_b32 v73, v72
  s_nop 1
  v_permlane32_swap_b32 v72, v73
  v_add_f32 v72, v72, v73
  v_cvt_pk_bf16_f32 v73, v72, v72
  v_lshlrev_b32 v72, 16, v73
  v_mul_f32 v72, 0xbfb8aa3b, v72
  v_exp_f32 v72, v72
  s_nop 0
  v_add_f32 v72, 1.0, v72
  v_rcp_f32 v72, v72
  s_nop 0
  v_cvt_pk_bf16_f32 v73, v72, v72
  v_lshlrev_b32 v72, 16, v73
  v_sub_f32 v73, 1.0, v72
  v_cvt_pk_bf16_f32 v74, v73, v73
  v_lshlrev_b32 v73, 16, v74
  s_mov_b64 exec, 1
  ds_write_b64 v3, v[72:73] offset:48
  s_mov_b64 exec, -1
  s_mov_b64 exec, 1
  v_mov_b32 v7, 1
  ds_write_b32 v3, v7 offset:32
  s_mov_b64 exec, -1
L_nogate:
  s_nop 1
  s_mov_b32 s42, 0x40000
LW_21:
  ds_read_b32 v72, v3 offset:4
  s_waitcnt lgkmcnt(0)
  v_readfirstlane_b32 s43, v72
  s_nop 1
  s_cmp_lt_u32 s43, 1
  s_cbranch_scc1 LR_23
LWD_22:
  ds_read_b64 v[72:73], v3 offset:40
  s_waitcnt lgkmcnt(0)
  v_readfirstlane_b32 s76, v72
  v_readfirstlane_b32 s77, v73
L_roles_done:
  s_nop 3
  v_and_b32 v98, 3, v0
  v_bfe_u32 v99, v0, 2, 2
  s_cmp_ge_u32 s6, 5
  s_cbranch_scc1 L_wd
  v_lshlrev_b32 v92, 4, v1
  v_mov_b32 v7, 5120
  v_mad_u32_u24 v92, v2, v7, v92
  s_lshl_b32 s9, s4, 7
  s_lshl_b32 s10, s3, 4
  s_add_u32 s9, s9, s10
  s_mul_i32 s9, s9, 1280
  s_lshl_b32 s10, s6, 8
  s_add_u32 s9, s9, s10
  v_and_b32 v7, 1, v98
  v_lshl_add_u32 v7, v99, 1, v7
  v_lshlrev_b32 v93, 4, v7
  s_lshl_b32 s10, s4, 7
  s_add_u32 s10, s10, 3145728
  v_lshlrev_b32 v6, 10, v7
  v_lshl_add_u32 v6, v2, 5, v6
  v_lshrrev_b32 v7, 1, v98
  v_lshl_add_u32 v94, v7, 4, v6
  s_lshl_b32 s12, s4, 13
  s_lshl_b32 s11, s3, 7
  s_add_u32 s12, s12, s11
  s_add_u32 s12, s12, 2621440
  s_lshl_b32 s11, s3, 11
  v_add_u32 v95, s11, v4
  s_lshl_b32 s11, s3, 9
  v_lshl_add_u32 v96, v0, 3, s11
  v_lshlrev_b32 v97, 1, v96
  s_lshl_b32 s13, s6, 6
  s_add_u32 s13, s13, s4
  s_lshl_b32 s13, s13, 12
  s_add_u32 s13, s13, 1048576
  s_setprio 0
  s_mov_b32 s42, 0x40000
LW_24:
  ds_read_b32 v72, v3 offset:28
  s_waitcnt lgkmcnt(0)
  v_readfirstlane_b32 s43, v72
  s_nop 1
  s_cmp_lt_u32 s43, 8
  s_cbranch_scc1 LR_26
LWD_25:
  s_mov_b32 s42, 20000
  s_mov_b64 s[92:93], -1
  s_mov_b64 exec, s[92:93]
  buffer_load_dwordx4 v[32:35], v93, s[44:47], s10 offen sc1
  s_mov_b64 exec, -1
  buffer_load_dwordx4 v[48:51], v92, s[60:63], s9 offen offset:0 nt
  buffer_load_dwordx4 v[52:55], v92, s[60:63], s9 offen offset:1280 nt
  buffer_load_dwordx4 v[56:59], v92, s[60:63], s9 offen offset:2560 nt
  buffer_load_dwordx4 v[60:63], v92, s[60:63], s9 offen offset:3840 nt
  s_waitcnt vmcnt(4)
  s_branch GC_29
G_27:
  s_mov_b64 exec, s[92:93]
  buffer_load_dwordx4 v[32:35], v93, s[44:47], s10 offen sc1
  s_waitcnt vmcnt(0)
GC_29:
  s_mov_b64 exec, s[92:93]
  v_cmp_ne_u64 s[92:93], s[76:77], v[34:35]
  s_mov_b64 exec, -1
  s_nop 0
  s_cmp_lg_u64 s[92:93], 0
  s_cbranch_scc1 GR_30
GD_28:
  v_max_f32_dpp v36, v32, v32 quad_perm:[1,0,3,2] row_mask:0xf bank_mask:0xf
  v_and_b32 v38, 15, v33
  v_sub_f32 v36, v32, v36
  v_cmp_eq_u32 vcc, s51, v38
  v_exp_f32 v36, v36
  v_add_u32 v38, 262144, v94
  v_cndmask_b32 v94, v94, v38, vcc
  v_mul_f32 v37, v36, v33
  v_mov_b32 v7, 1
  s_nop 0
  v_add_f32_dpp v37, v37, v37 quad_perm:[1,0,3,2] row_mask:0xf bank_mask:0xf
  v_rcp_f32 v37, v37
  s_nop 0
  v_mul_f32 v36, v36, v37
  s_mov_b32 s42, 0x40000
LW_31:
  ds_read_b32 v72, v3 offset:24
  s_waitcnt lgkmcnt(0)
  v_readfirstlane_b32 s43, v72
  s_nop 1
  s_cmp_lt_u32 s43, 8
  s_cbranch_scc1 LR_33
LWD_32:
  s_mov_b32 s42, 20000
  s_mov_b64 s[92:93], -1
G_34:
  s_mov_b64 exec, s[92:93]
  buffer_load_dwordx4 v[28:31], v94, s[44:47], s12 offen sc1
  s_waitcnt vmcnt(0)
GC_36:
  s_mov_b64 exec, s[92:93]
  v_cmp_ne_u64 s[92:93], s[76:77], v[30:31]
  s_mov_b64 exec, -1
  s_nop 0
  s_cmp_lg_u64 s[92:93], 0
  s_cbranch_scc1 GR_37
GD_35:
  v_mul_f32 v28, v36, v28
  v_mul_f32 v29, v36, v29
  s_nop 0
  v_add_f32_dpp v28, v28, v28 quad_perm:[1,0,3,2] row_mask:0xf bank_mask:0xf
  v_add_f32_dpp v29, v29, v29 quad_perm:[1,0,3,2] row_mask:0xf bank_mask:0xf
  v_cvt_pk_bf16_f32 v28, v28, v29
  s_nop 1
  v_mov_b32_dpp v30, v28 quad_perm:[0,0,0,0] row_mask:0xf bank_mask:0xf
  v_mov_b32_dpp v31, v28 quad_perm:[2,2,2,2] row_mask:0xf bank_mask:0xf
  v_perm_b32 v80, v30, v30, v64
  v_perm_b32 v81, v30, v30, v65
  v_perm_b32 v82, v30, v30, v66
  v_perm_b32 v83, v30, v30, v67
  v_perm_b32 v84, v31, v31, v64
  v_perm_b32 v85, v31, v31, v65
  v_perm_b32 v86, v31, v31, v66
  v_perm_b32 v87, v31, v31, v67
  v_mfma_f32_16x16x16_bf16 v[8:11], v[80:81], v[48:49], 0
  v_mfma_f32_16x16x16_bf16 v[12:15], v[80:81], v[50:51], 0
  v_mfma_f32_16x16x16_bf16 v[8:11], v[82:83], v[52:53], v[8:11]
  v_mfma_f32_16x16x16_bf16 v[12:15], v[82:83], v[54:55], v[12:15]
  v_mfma_f32_16x16x16_bf16 v[8:11], v[84:85], v[56:57], v[8:11]
  v_mfma_f32_16x16x16_bf16 v[12:15], v[84:85], v[58:59], v[12:15]
  v_mfma_f32_16x16x16_bf16 v[8:11], v[86:87], v[60:61], v[8:11]
  v_mfma_f32_16x16x16_bf16 v[12:15], v[86:87], v[62:63], v[12:15]
  s_nop 6
  ds_write_b128 v95, v[8:11] offset:17408
  ds_write_b128 v95, v[12:15] offset:17424
  s_cmp_ge_u32 s3, 4
  s_waitcnt lgkmcnt(0)
  s_barrier
  s_cbranch_scc1 L_end
  ds_read_b64 v[72:73], v96 offset:17408
  ds_read_b64 v[76:77], v96 offset:19456
  ds_read_b64 v[78:79], v96 offset:21504
  ds_read_b64 v[80:81], v96 offset:23552
  ds_read_b64 v[82:83], v96 offset:25600
  ds_read_b64 v[84:85], v96 offset:27648
  ds_read_b64 v[86:87], v96 offset:29696
  ds_read_b64 v[88:89], v96 offset:31744
  v_mov_b32 v74, s76
  v_mov_b32 v75, s77
  s_waitcnt lgkmcnt(4)
  v_pk_add_f32 v[72:73], v[72:73], v[76:77]
  v_pk_add_f32 v[78:79], v[78:79], v[80:81]
  s_waitcnt lgkmcnt(0)
  v_pk_add_f32 v[82:83], v[82:83], v[84:85]
  v_pk_add_f32 v[86:87], v[86:87], v[88:89]
  v_pk_add_f32 v[72:73], v[72:73], v[78:79]
  v_pk_add_f32 v[82:83], v[82:83], v[86:87]
  v_pk_add_f32 v[72:73], v[72:73], v[82:83]
  buffer_store_dwordx4 v[72:75], v97, s[44:47], s13 offen sc1
  s_nop 1
  s_branch L_end
L_wd:
  s_nop 1
  s_cmp_ge_u32 s52, 27
  s_cbranch_scc1 L_end
  v_lshlrev_b32 v92, 4, v1
  v_mov_b32 v7, 2560
  v_mad_u32_u24 v92, v2, v7, v92
  s_lshl_b32 s9, s52, 6
  s_lshl_b32 s10, s3, 3
  s_add_u32 s9, s9, s10
  s_mul_i32 s9, s9, 1280
  s_sub_u32 s10, s6, 5
  s_lshl_b32 s10, s10, 9
  s_add_u32 s9, s9, s10
  s_cmp_lt_u32 s6, 7
  s_cselect_b32 s10, s9, 0x7fff0000
  v_lshrrev_b32 v6, 1, v98
  v_lshlrev_b32 v6, 12, v6
  v_lshl_add_u32 v6, v99, 7, v6
  v_and_b32 v7, 1, v98
  v_lshl_add_u32 v6, v7, 6, v6
  v_lshl_add_u32 v93, v2, 4, v6
  s_lshl_b32 s11, s52, 14
  s_add_u32 s11, s11, 524288
  s_lshl_b32 s12, s3, 9
  s_add_u32 s11, s11, s12
  s_add_u32 s12, s11, 8192
  s_lshl_b32 s13, s3, 12
  v_add_u32 v95, s13, v4
  s_lshl_b32 s13, s3, 9
  v_lshl_add_u32 v96, v0, 3, s13
  s_and_b32 s13, s3, 3
  s_lshl_b32 s13, s13, 10
  v_lshl_add_u32 v97, v0, 4, s13
  s_lshr_b32 s13, s3, 2
  s_sub_u32 s14, s6, 5
  s_lshl_b32 s14, s14, 1
  s_add_u32 s14, s14, s13
  s_lshl_b32 s13, s14, 6
  s_add_u32 s13, s13, s52
  s_add_u32 s13, s13, 32
  s_lshl_b32 s13, s13, 12
  s_add_u32 s13, s13, 1048576
  s_setprio 0
  s_mov_b32 s42, 0x40000
LW_38:
  ds_read_b32 v72, v3 offset:28
  s_waitcnt lgkmcnt(0)
  v_readfirstlane_b32 s43, v72
  s_nop 1
  s_cmp_lt_u32 s43, 8
  s_cbranch_scc1 LR_40
LWD_39:
  s_mov_b32 s42, 20000
  s_mov_b64 s[92:93], -1
  s_mov_b64 s[94:95], -1
  s_mov_b64 exec, s[92:93]
  buffer_load_dwordx4 v[28:31], v93, s[44:47], s11 offen sc1
  s_mov_b64 exec, s[94:95]
  buffer_load_dwordx4 v[32:35], v93, s[44:47], s12 offen sc1
  s_mov_b64 exec, -1
  buffer_load_dwordx4 v[48:51], v92, s[60:63], s9 offen offset:0 nt
  buffer_load_dwordx4 v[52:55], v92, s[60:63], s9 offen offset:1280 nt
  buffer_load_dwordx4 v[56:59], v92, s[60:63], s10 offen offset:256 nt
  buffer_load_dwordx4 v[60:63], v92, s[60:63], s10 offen offset:1536 nt
  s_waitcnt vmcnt(4)
  s_branch GC_43
G_41:
  s_mov_b64 exec, s[92:93]
  buffer_load_dwordx4 v[28:31], v93, s[44:47], s11 offen sc1
  s_mov_b64 exec, s[94:95]
  buffer_load_dwordx4 v[32:35], v93, s[44:47], s12 offen sc1
  s_waitcnt vmcnt(0)
GC_43:
  s_mov_b64 exec, s[92:93]
  v_cmp_ne_u64 s[92:93], s[76:77], v[30:31]
  s_mov_b64 exec, s[94:95]
  v_cmp_ne_u64 s[94:95], s[76:77], v[34:35]
  s_mov_b64 exec, -1
  s_nop 0
  s_or_b64 s[78:79], s[92:93], s[94:95]
  s_cbranch_scc1 GR_44
GD_42:
  v_pk_add_f32 v[28:29], v[28:29], v[32:33]
  s_nop 1
  v_add_f32_dpp v28, v28, v28 quad_perm:[2,3,0,1] row_mask:0xf bank_mask:0xf
  v_add_f32_dpp v29, v29, v29 quad_perm:[2,3,0,1] row_mask:0xf bank_mask:0xf
  v_cvt_pk_bf16_f32 v28, v28, v29
  s_nop 1
  v_mov_b32_dpp v30, v28 quad_perm:[0,0,0,0] row_mask:0xf bank_mask:0xf
  v_mov_b32_dpp v31, v28 quad_perm:[1,1,1,1] row_mask:0xf bank_mask:0xf
  v_lshlrev_b32 v32, 16, v30
  v_and_b32 v33, 0xffff0000, v30
  v_lshlrev_b32 v34, 16, v31
  v_and_b32 v35, 0xffff0000, v31
  v_mul_f32 v36, v32, v32
  v_mul_f32 v37, v33, v33
  v_mul_f32 v36, 0x3d372713, v36
  v_mul_f32 v37, 0x3d372713, v37
  v_fma_f32 v36, v36, v32, v32
  v_fma_f32 v37, v37, v33, v33
  v_mul_f32 v36, 0xc0135761, v36
  v_mul_f32 v37, 0xc0135761, v37
  v_exp_f32 v36, v36
  v_exp_f32 v37, v37
  v_add_f32 v36, 1.0, v36
  v_add_f32 v37, 1.0, v37
  v_rcp_f32 v36, v36
  v_rcp_f32 v37, v37
  v_mul_f32 v32, v32, v36
  v_mul_f32 v33, v33, v37
  v_cvt_pk_bf16_f32 v36, v32, v33
  v_lshlrev_b32 v32, 16, v36
  v_and_b32 v33, 0xffff0000, v36
  v_mul_f32 v32, v32, v34
  v_mul_f32 v33, v33, v35
  v_cvt_pk_bf16_f32 v36, v32, v33
  v_perm_b32 v80, v36, v36, v64
  v_perm_b32 v81, v36, v36, v65
  v_perm_b32 v82, v36, v36, v66
  v_perm_b32 v83, v36, v36, v67
  s_waitcnt vmcnt(0)
  v_mfma_f32_16x16x16_bf16 v[8:11], v[80:81], v[48:49], 0
  v_mfma_f32_16x16x16_bf16 v[12:15], v[80:81], v[50:51], 0
  v_mfma_f32_16x16x16_bf16 v[8:11], v[82:83], v[52:53], v[8:11]
  v_mfma_f32_16x16x16_bf16 v[12:15], v[82:83], v[54:55], v[12:15]
  v_mfma_f32_16x16x16_bf16 v[16:19], v[80:81], v[56:57], 0
  v_mfma_f32_16x16x16_bf16 v[20:23], v[80:81], v[58:59], 0
  v_mfma_f32_16x16x16_bf16 v[16:19], v[82:83], v[60:61], v[16:19]
  v_mfma_f32_16x16x16_bf16 v[20:23], v[82:83], v[62:63], v[20:23]
  s_nop 2
  ds_write_b128 v95, v[8:11] offset:17408
  ds_write_b128 v95, v[12:15] offset:17424
  s_nop 1
  ds_write_b128 v95, v[16:19] offset:19456
  ds_write_b128 v95, v[20:23] offset:19472
  s_mov_b64 exec, 1
  v_mov_b32 v7, 1
  ds_add_u32 v3, v7 offset:20
  s_mov_b64 exec, -1
  s_cmp_ge_u32 s14, 5
  s_cbranch_scc1 L_end
  s_mov_b32 s42, 0x40000
LW_45:
  ds_read_b32 v72, v3 offset:20
  s_waitcnt lgkmcnt(0)
  v_readfirstlane_b32 s43, v72
  s_nop 1
  s_cmp_lt_u32 s43, 8
  s_cbranch_scc1 LR_47
LWD_46:
  ds_read_b64 v[72:73], v96 offset:17408
  ds_read_b64 v[76:77], v96 offset:21504
  ds_read_b64 v[78:79], v96 offset:25600
  ds_read_b64 v[80:81], v96 offset:29696
  ds_read_b64 v[82:83], v96 offset:33792
  ds_read_b64 v[84:85], v96 offset:37888
  ds_read_b64 v[86:87], v96 offset:41984
  ds_read_b64 v[88:89], v96 offset:46080
  v_mov_b32 v74, s76
  v_mov_b32 v75, s77
  s_waitcnt lgkmcnt(4)
  v_pk_add_f32 v[72:73], v[72:73], v[76:77]
  v_pk_add_f32 v[78:79], v[78:79], v[80:81]
  s_waitcnt lgkmcnt(0)
  v_pk_add_f32 v[82:83], v[82:83], v[84:85]
  v_pk_add_f32 v[86:87], v[86:87], v[88:89]
  v_pk_add_f32 v[72:73], v[72:73], v[78:79]
  v_pk_add_f32 v[82:83], v[82:83], v[86:87]
  v_pk_add_f32 v[72:73], v[72:73], v[82:83]
  buffer_store_dwordx4 v[72:75], v97, s[44:47], s13 offen sc1
  s_nop 1
  s_branch L_end
L_S:
  s_nop 3
  s_sub_u32 s3, s3, 8
  s_mul_i32 s14, s3, 5
  s_add_u32 s14, s14, s8
  s_add_u32 s14, s14, s2
  s_bfe_u32 s15, s14, 0x20004
  s_and_b32 s14, s14, 15
  v_bfe_u32 v1, v0, 2, 2
  v_xor_b32 v1, s15, v1
  v_lshlrev_b32 v1, 8, v1
  v_and_b32 v2, 3, v0
  v_lshrrev_b32 v3, 4, v0
  v_lshl_add_u32 v2, v3, 2, v2
  v_lshlrev_b32 v4, 4, v2
  v_add_u32 v1, v4, v1
  s_and_b32 s10, s14, 3
  v_xor_b32 v3, s10, v3
  v_and_b32 v2, 15, v0
  v_lshlrev_b32 v2, 4, v2
  v_lshl_add_u32 v2, v3, 10, v2
  v_mov_b32 v3, 0
  s_lshl_b32 s9, s5, 5
  s_add_u32 s9, s9, s4
  s_lshl_b32 s9, s9, 20
  s_and_b32 s10, s6, 1
  s_lshl_b32 s10, s10, 17
  s_add_u32 s9, s9, s10
  s_lshl_b32 s10, s3, 14
  s_add_u32 s9, s9, s10
  s_add_u32 s9, s9, 0xC0000
  s_lshl_b32 s14, s14, 10
  s_and_b32 s13, s14, 0x3000
  s_lshl_b32 s15, s15, 8
  s_or_b32 s13, s13, s15
  s_waitcnt lgkmcnt(0)
  s_mov_b32 s48, s18
  s_and_b32 s49, s19, 0xffff
  s_mov_b32 s50, 134217728
  s_mov_b32 s51, 0x20000
  s_mov_b32 s52, s20
  s_and_b32 s53, s21, 0xffff
  s_mov_b32 s54, 134217728
  s_mov_b32 s55, 0x20000
  s_mov_b32 s44, s40
  s_and_b32 s45, s41, 0xffff
  s_mov_b32 s46, 4194304
  s_mov_b32 s47, 0x20000
  s_mov_b32 s56, s36
  s_and_b32 s57, s37, 0xffff
  s_mov_b32 s58, 5120
  s_mov_b32 s59, 0x20000
  s_barrier
  s_xor_b32 s10, s14, 0
  s_add_u32 s10, s10, s9
  buffer_load_dwordx4 v[64:67], v1, s[48:51], s10 offen nt
  s_xor_b32 s10, s14, 1024
  s_add_u32 s10, s10, s9
  buffer_load_dwordx4 v[68:71], v1, s[48:51], s10 offen nt
  s_waitcnt vmcnt(1)
  s_xor_b32 s10, s14, 2048
  s_add_u32 s10, s10, s9
  buffer_load_dwordx4 v[72:75], v1, s[48:51], s10 offen nt
  s_waitcnt vmcnt(1)
  s_xor_b32 s10, s14, 3072
  s_add_u32 s10, s10, s9
  buffer_load_dwordx4 v[76:79], v1, s[48:51], s10 offen nt
  s_waitcnt vmcnt(2)
  s_xor_b32 s10, s14, 4096
  s_add_u32 s10, s10, s9
  buffer_load_dwordx4 v[80:83], v1, s[48:51], s10 offen nt
  s_waitcnt vmcnt(2)
  s_xor_b32 s10, s14, 5120
  s_add_u32 s10, s10, s9
  buffer_load_dwordx4 v[84:87], v1, s[48:51], s10 offen nt
  s_waitcnt vmcnt(2)
  s_xor_b32 s10, s14, 6144
  s_add_u32 s10, s10, s9
  buffer_load_dwordx4 v[88:91], v1, s[48:51], s10 offen nt
  s_waitcnt vmcnt(2)
  s_xor_b32 s10, s14, 7168
  s_add_u32 s10, s10, s9
  buffer_load_dwordx4 v[92:95], v1, s[48:51], s10 offen nt
  s_waitcnt vmcnt(2)
  s_xor_b32 s10, s14, 8192
  s_add_u32 s10, s10, s9
  buffer_load_dwordx4 v[96:99], v1, s[48:51], s10 offen nt
  s_waitcnt vmcnt(2)
  s_xor_b32 s10, s14, 9216
  s_add_u32 s10, s10, s9
  buffer_load_dwordx4 v[100:103], v1, s[48:51], s10 offen nt
  s_waitcnt vmcnt(2)
  s_xor_b32 s10, s14, 10240
  s_add_u32 s10, s10, s9
  buffer_load_dwordx4 v[104:107], v1, s[48:51], s10 offen nt
  s_waitcnt vmcnt(2)
  s_xor_b32 s10, s14, 11264
  s_add_u32 s10, s10, s9
  buffer_load_dwordx4 v[108:111], v1, s[48:51], s10 offen nt
  s_waitcnt vmcnt(2)
  s_xor_b32 s10, s14, 12288
  s_add_u32 s10, s10, s9
  buffer_load_dwordx4 v[112:115], v1, s[48:51], s10 offen nt
  s_waitcnt vmcnt(2)
  s_xor_b32 s10, s14, 13312
  s_add_u32 s10, s10, s9
  buffer_load_dwordx4 v[116:119], v1, s[48:51], s10 offen nt
  s_waitcnt vmcnt(2)
  s_xor_b32 s10, s14, 14336
  s_add_u32 s10, s10, s9
  buffer_load_dwordx4 v[120:123], v1, s[48:51], s10 offen nt
  s_waitcnt vmcnt(2)
  s_xor_b32 s10, s14, 15360
  s_add_u32 s10, s10, s9
  buffer_load_dwordx4 v[124:127], v1, s[48:51], s10 offen nt
  s_waitcnt vmcnt(2)
  s_xor_b32 s10, s13, 0
  s_add_u32 s10, s10, s9
  buffer_load_dwordx4 v[32:35], v2, s[52:55], s10 offen nt
  s_waitcnt vmcnt(2)
  s_xor_b32 s10, s13, 256
  s_add_u32 s10, s10, s9
  buffer_load_dwordx4 v[36:39], v2, s[52:55], s10 offen nt
  s_waitcnt vmcnt(2)
  s_xor_b32 s10, s13, 512
  s_add_u32 s10, s10, s9
  buffer_load_dwordx4 v[40:43], v2, s[52:55], s10 offen nt
  s_waitcnt vmcnt(2)
  s_xor_b32 s10, s13, 768
  s_add_u32 s10, s10, s9
  buffer_load_dwordx4 v[44:47], v2, s[52:55], s10 offen nt
  s_waitcnt vmcnt(2)
  s_xor_b32 s10, s13, 4096
  s_add_u32 s10, s10, s9
  buffer_load_dwordx4 v[48:51], v2, s[52:55], s10 offen nt
  s_waitcnt vmcnt(2)
  s_xor_b32 s10, s13, 4352
  s_add_u32 s10, s10, s9
  buffer_load_dwordx4 v[52:55], v2, s[52:55], s10 offen nt
  s_waitcnt vmcnt(2)
  s_xor_b32 s10, s13, 4608
  s_add_u32 s10, s10, s9
  buffer_load_dwordx4 v[56:59], v2, s[52:55], s10 offen nt
  s_waitcnt vmcnt(2)
  s_xor_b32 s10, s13, 4864
  s_add_u32 s10, s10, s9
  buffer_load_dwordx4 v[60:63], v2, s[52:55], s10 offen nt
  s_mov_b32 s42, 0x40000
LW_48:
  ds_read_b32 v5, v3 offset:8
  s_waitcnt lgkmcnt(0)
  v_readfirstlane_b32 s43, v5
  s_nop 1
  s_cmp_lt_u32 s43, 1
  s_cbranch_scc1 LR_50
LWD_49:
  s_setprio 1
  ds_read_b128 v[12:15], v4 offset:50176
  v_bfe_u32 v5, v0, 2, 2
  s_waitcnt vmcnt(8)
  s_waitcnt lgkmcnt(0)
  v_cmp_eq_u32 vcc, 0, v5
  s_nop 1
  v_cndmask_b32 v16, 0, v12, vcc
  v_cndmask_b32 v17, 0, v13, vcc
  v_cndmask_b32 v18, 0, v14, vcc
  v_cndmask_b32 v19, 0, v15, vcc
  v_cmp_eq_u32 vcc, 1, v5
  s_nop 1
  v_cndmask_b32 v20, 0, v12, vcc
  v_cndmask_b32 v21, 0, v13, vcc
  v_cndmask_b32 v22, 0, v14, vcc
  v_cndmask_b32 v23, 0, v15, vcc
  v_cmp_eq_u32 vcc, 2, v5
  s_nop 1
  v_cndmask_b32 v24, 0, v12, vcc
  v_cndmask_b32 v25, 0, v13, vcc
  v_cndmask_b32 v26, 0, v14, vcc
  v_cndmask_b32 v27, 0, v15, vcc
  v_cmp_eq_u32 vcc, 3, v5
  s_nop 1
  v_cndmask_b32 v28, 0, v12, vcc
  v_cndmask_b32 v29, 0, v13, vcc
  v_cndmask_b32 v30, 0, v14, vcc
  v_cndmask_b32 v31, 0, v15, vcc
  v_mfma_f32_16x16x32_bf16 v[8:11], v[16:19], v[64:67], 0
  v_mfma_f32_16x16x32_bf16 v[8:11], v[20:23], v[68:71], v[8:11]
  v_mfma_f32_16x16x32_bf16 v[8:11], v[24:27], v[72:75], v[8:11]
  v_mfma_f32_16x16x32_bf16 v[8:11], v[28:31], v[76:79], v[8:11]
  v_mfma_f32_16x16x32_bf16 v[12:15], v[16:19], v[80:83], 0
  v_mfma_f32_16x16x32_bf16 v[12:15], v[20:23], v[84:87], v[12:15]
  v_mfma_f32_16x16x32_bf16 v[12:15], v[24:27], v[88:91], v[12:15]
  v_mfma_f32_16x16x32_bf16 v[12:15], v[28:31], v[92:95], v[12:15]
  s_xor_b32 s10, s13, 8192
  s_add_u32 s10, s10, s9
  buffer_load_dwordx4 v[64:67], v2, s[52:55], s10 offen nt
  s_xor_b32 s10, s13, 8448
  s_add_u32 s10, s10, s9
  buffer_load_dwordx4 v[68:71], v2, s[52:55], s10 offen nt
  v_mov_b32_dpp v4, v8 quad_perm:[0,0,0,0] row_mask:0xf bank_mask:0xf
  s_nop 1
  v_add_f32_dpp v4, v9, v4 quad_perm:[1,1,1,1] row_mask:0xf bank_mask:0xf
  s_nop 1
  v_add_f32_dpp v4, v10, v4 quad_perm:[2,2,2,2] row_mask:0xf bank_mask:0xf
  s_nop 1
  v_add_f32_dpp v4, v11, v4 quad_perm:[3,3,3,3] row_mask:0xf bank_mask:0xf
  v_mfma_f32_16x16x32_bf16 v[8:11], v[16:19], v[96:99], 0
  v_mfma_f32_16x16x32_bf16 v[8:11], v[20:23], v[100:103], v[8:11]
  v_mfma_f32_16x16x32_bf16 v[8:11], v[24:27], v[104:107], v[8:11]
  v_mfma_f32_16x16x32_bf16 v[8:11], v[28:31], v[108:111], v[8:11]
  v_mov_b32_dpp v5, v12 quad_perm:[0,0,0,0] row_mask:0xf bank_mask:0xf
  s_nop 1
  v_add_f32_dpp v5, v13, v5 quad_perm:[1,1,1,1] row_mask:0xf bank_mask:0xf
  s_nop 1
  v_add_f32_dpp v5, v14, v5 quad_perm:[2,2,2,2] row_mask:0xf bank_mask:0xf
  s_nop 1
  v_add_f32_dpp v5, v15, v5 quad_perm:[3,3,3,3] row_mask:0xf bank_mask:0xf
  v_mfma_f32_16x16x32_bf16 v[12:15], v[16:19], v[112:115], 0
  v_mfma_f32_16x16x32_bf16 v[12:15], v[20:23], v[116:119], v[12:15]
  v_mfma_f32_16x16x32_bf16 v[12:15], v[24:27], v[120:123], v[12:15]
  v_mfma_f32_16x16x32_bf16 v[12:15], v[28:31], v[124:127], v[12:15]
  v_mov_b32_dpp v6, v8 quad_perm:[0,0,0,0] row_mask:0xf bank_mask:0xf
  s_nop 1
  v_add_f32_dpp v6, v9, v6 quad_perm:[1,1,1,1] row_mask:0xf bank_mask:0xf
  s_nop 1
  v_add_f32_dpp v6, v10, v6 quad_perm:[2,2,2,2] row_mask:0xf bank_mask:0xf
  s_nop 1
  v_add_f32_dpp v6, v11, v6 quad_perm:[3,3,3,3] row_mask:0xf bank_mask:0xf
  v_mov_b32_dpp v7, v12 quad_perm:[0,0,0,0] row_mask:0xf bank_mask:0xf
  s_nop 1
  v_add_f32_dpp v7, v13, v7 quad_perm:[1,1,1,1] row_mask:0xf bank_mask:0xf
  s_nop 1
  v_add_f32_dpp v7, v14, v7 quad_perm:[2,2,2,2] row_mask:0xf bank_mask:0xf
  s_nop 1
  v_add_f32_dpp v7, v15, v7 quad_perm:[3,3,3,3] row_mask:0xf bank_mask:0xf
  v_cvt_pk_bf16_f32 v8, v4, v5
  v_cvt_pk_bf16_f32 v9, v6, v7
  s_mov_b32 s11, 0x3db504f3
  s_mov_b32 s12, 0x3fb8aa3b
  v_lshlrev_b32 v4, 16, v8
  v_and_b32 v5, 0xffff0000, v8
  v_lshlrev_b32 v6, 16, v9
  v_and_b32 v7, 0xffff0000, v9
  v_mul_f32 v4, s11, v4
  v_mul_f32 v5, s11, v5
  v_mul_f32 v6, s11, v6
  v_mul_f32 v7, s11, v7
  v_cvt_pk_bf16_f32 v8, v4, v5
  v_cvt_pk_bf16_f32 v9, v6, v7
  v_lshlrev_b32 v4, 16, v8
  v_and_b32 v5, 0xffff0000, v8
  v_lshlrev_b32 v6, 16, v9
  v_and_b32 v7, 0xffff0000, v9
  v_mul_f32 v4, s12, v4
  v_mul_f32 v5, s12, v5
  v_mul_f32 v6, s12, v6
  v_mul_f32 v7, s12, v7
  v_max3_f32 v8, v4, v5, v6
  v_max_f32 v8, v8, v7
  s_nop 1
  v_max_f32_dpp v8, v8, v8 row_ror:4 row_mask:0xf bank_mask:0xf
  s_nop 1
  v_max_f32_dpp v8, v8, v8 row_ror:8 row_mask:0xf bank_mask:0xf
  v_mov_b32 v9, v8
  s_nop 1
  v_permlane16_swap_b32 v8, v9
  v_max_f32 v8, v8, v9
  v_mov_b32 v9, v8
  s_nop 1
  v_permlane32_swap_b32 v8, v9
  v_max_f32 v8, v8, v9
  v_sub_f32 v4, v4, v8
  v_sub_f32 v5, v5, v8
  v_sub_f32 v6, v6, v8
  v_sub_f32 v7, v7, v8
  v_exp_f32 v4, v4
  v_exp_f32 v5, v5
  v_exp_f32 v6, v6
  v_exp_f32 v7, v7
  v_add_f32 v10, v4, v5
  v_add_f32 v11, v6, v7
  v_add_f32 v10, v10, v11
  s_nop 1
  v_add_f32_dpp v10, v10, v10 row_ror:4 row_mask:0xf bank_mask:0xf
  s_nop 1
  v_add_f32_dpp v10, v10, v10 row_ror:8 row_mask:0xf bank_mask:0xf
  v_mov_b32 v9, v10
  s_nop 1
  v_permlane16_swap_b32 v10, v9
  v_add_f32 v10, v10, v9
  v_mov_b32 v9, v10
  s_nop 1
  v_permlane32_swap_b32 v10, v9
  v_add_f32 v10, v10, v9
  s_lshl_b32 s11, s3, 2
  v_mov_b32 v9, s11
  s_mov_b64 exec, 1
  ds_write_b32 v9, v8 offset:64
  ds_write_b32 v9, v10 offset:96
  s_mov_b64 exec, -1
  s_mov_b64 exec, 1
  v_mov_b32 v11, 1
  ds_add_u32 v3, v11 offset:16
  s_mov_b64 exec, -1
  s_xor_b32 s10, s13, 8704
  s_add_u32 s10, s10, s9
  buffer_load_dwordx4 v[72:75], v2, s[52:55], s10 offen nt
  s_xor_b32 s10, s13, 8960
  s_add_u32 s10, s10, s9
  buffer_load_dwordx4 v[76:79], v2, s[52:55], s10 offen nt
  v_cvt_pk_bf16_f32 v4, v4, v4
  v_cvt_pk_bf16_f32 v5, v5, v5
  v_cvt_pk_bf16_f32 v6, v6, v6
  v_cvt_pk_bf16_f32 v7, v7, v7
  v_and_b32 v12, 1, v0
  v_lshlrev_b32 v12, 4, v12
  v_mov_b32 v13, 0xffff
  v_lshlrev_b32 v12, v12, v13
  v_bfe_u32 v13, v0, 1, 3
  v_cmp_eq_u32 vcc, 0, v13
  s_nop 1
  v_cndmask_b32 v8, 0, v12, vcc
  v_cmp_eq_u32 vcc, 1, v13
  s_nop 1
  v_cndmask_b32 v9, 0, v12, vcc
  v_cmp_eq_u32 vcc, 2, v13
  s_nop 1
  v_cndmask_b32 v10, 0, v12, vcc
  v_cmp_eq_u32 vcc, 3, v13
  s_nop 1
  v_cndmask_b32 v11, 0, v12, vcc
  v_and_b32_dpp v16, v4, v8 row_newbcast:0 row_mask:0xf bank_mask:0xf
  v_and_b32_dpp v17, v4, v9 row_newbcast:0 row_mask:0xf bank_mask:0xf
  v_and_b32_dpp v18, v4, v10 row_newbcast:0 row_mask:0xf bank_mask:0xf
  v_and_b32_dpp v19, v4, v11 row_newbcast:0 row_mask:0xf bank_mask:0xf
  v_and_b32_dpp v20, v4, v8 row_newbcast:4 row_mask:0xf bank_mask:0xf
  v_and_b32_dpp v21, v4, v9 row_newbcast:4 row_mask:0xf bank_mask:0xf
  v_and_b32_dpp v22, v4, v10 row_newbcast:4 row_mask:0xf bank_mask:0xf
  v_and_b32_dpp v23, v4, v11 row_newbcast:4 row_mask:0xf bank_mask:0xf
  v_and_b32_dpp v24, v4, v8 row_newbcast:8 row_mask:0xf bank_mask:0xf
  v_and_b32_dpp v25, v4, v9 row_newbcast:8 row_mask:0xf bank_mask:0xf
  v_and_b32_dpp v26, v4, v10 row_newbcast:8 row_mask:0xf bank_mask:0xf
  v_and_b32_dpp v27, v4, v11 row_newbcast:8 row_mask:0xf bank_mask:0xf
  v_and_b32_dpp v28, v4, v8 row_newbcast:12 row_mask:0xf bank_mask:0xf
  v_and_b32_dpp v29, v4, v9 row_newbcast:12 row_mask:0xf bank_mask:0xf
  v_and_b32_dpp v30, v4, v10 row_newbcast:12 row_mask:0xf bank_mask:0xf
  v_and_b32_dpp v31, v4, v11 row_newbcast:12 row_mask:0xf bank_mask:0xf
  s_waitcnt vmcnt(11)
  s_xor_b32 s10, s13, 12288
  s_add_u32 s10, s10, s9
  buffer_load_dwordx4 v[80:83], v2, s[52:55], s10 offen nt
  s_xor_b32 s10, s13, 12544
  s_add_u32 s10, s10, s9
  buffer_load_dwordx4 v[84:87], v2, s[52:55], s10 offen nt
  s_xor_b32 s10, s13, 12800
  s_add_u32 s10, s10, s9
  buffer_load_dwordx4 v[88:91], v2, s[52:55], s10 offen nt
  s_xor_b32 s10, s13, 13056
  s_add_u32 s10, s10, s9
  buffer_load_dwordx4 v[92:95], v2, s[52:55], s10 offen nt
  s_mov_b64 exec, 1
  v_mov_b32 v1, 1
  ds_add_u32 v3, v1 offset:28
  s_mov_b64 exec, -1
  v_mfma_f32_16x16x32_bf16 v[12:15], v[16:19], v[32:35], 0
  v_and_b32_dpp v16, v5, v8 row_newbcast:0 row_mask:0xf bank_mask:0xf
  v_and_b32_dpp v17, v5, v9 row_newbcast:0 row_mask:0xf bank_mask:0xf
  v_and_b32_dpp v18, v5, v10 row_newbcast:0 row_mask:0xf bank_mask:0xf
  v_and_b32_dpp v19, v5, v11 row_newbcast:0 row_mask:0xf bank_mask:0xf
  s_waitcnt vmcnt(14)
  v_mfma_f32_16x16x32_bf16 v[12:15], v[20:23], v[36:39], v[12:15]
  v_and_b32_dpp v20, v5, v8 row_newbcast:4 row_mask:0xf bank_mask:0xf
  v_and_b32_dpp v21, v5, v9 row_newbcast:4 row_mask:0xf bank_mask:0xf
  v_and_b32_dpp v22, v5, v10 row_newbcast:4 row_mask:0xf bank_mask:0xf
  v_and_b32_dpp v23, v5, v11 row_newbcast:4 row_mask:0xf bank_mask:0xf
  s_waitcnt vmcnt(13)
  v_mfma_f32_16x16x32_bf16 v[12:15], v[24:27], v[40:43], v[12:15]
  v_and_b32_dpp v24, v5, v8 row_newbcast:8 row_mask:0xf bank_mask:0xf
  v_and_b32_dpp v25, v5, v9 row_newbcast:8 row_mask:0xf bank_mask:0xf
  v_and_b32_dpp v26, v5, v10 row_newbcast:8 row_mask:0xf bank_mask:0xf
  v_and_b32_dpp v27, v5, v11 row_newbcast:8 row_mask:0xf bank_mask:0xf
  s_waitcnt vmcnt(12)
  v_mfma_f32_16x16x32_bf16 v[12:15], v[28:31], v[44:47], v[12:15]
  v_and_b32_dpp v28, v5, v8 row_newbcast:12 row_mask:0xf bank_mask:0xf
  v_and_b32_dpp v29, v5, v9 row_newbcast:12 row_mask:0xf bank_mask:0xf
  v_and_b32_dpp v30, v5, v10 row_newbcast:12 row_mask:0xf bank_mask:0xf
  v_and_b32_dpp v31, v5, v11 row_newbcast:12 row_mask:0xf bank_mask:0xf
  s_waitcnt vmcnt(11)
  v_mfma_f32_16x16x32_bf16 v[12:15], v[16:19], v[48:51], v[12:15]
  v_and_b32_dpp v96, v6, v8 row_newbcast:0 row_mask:0xf bank_mask:0xf
  v_and_b32_dpp v97, v6, v9 row_newbcast:0 row_mask:0xf bank_mask:0xf
  v_and_b32_dpp v98, v6, v10 row_newbcast:0 row_mask:0xf bank_mask:0xf
  v_and_b32_dpp v99, v6, v11 row_newbcast:0 row_mask:0xf bank_mask:0xf
  v_and_b32_dpp v100, v6, v8 row_newbcast:4 row_mask:0xf bank_mask:0xf
  v_and_b32_dpp v101, v6, v9 row_newbcast:4 row_mask:0xf bank_mask:0xf
  v_and_b32_dpp v102, v6, v10 row_newbcast:4 row_mask:0xf bank_mask:0xf
  v_and_b32_dpp v103, v6, v11 row_newbcast:4 row_mask:0xf bank_mask:0xf
  s_waitcnt vmcnt(10)
  v_mfma_f32_16x16x32_bf16 v[12:15], v[20:23], v[52:55], v[12:15]
  v_and_b32_dpp v104, v6, v8 row_newbcast:8 row_mask:0xf bank_mask:0xf
  v_and_b32_dpp v105, v6, v9 row_newbcast:8 row_mask:0xf bank_mask:0xf
  v_and_b32_dpp v106, v6, v10 row_newbcast:8 row_mask:0xf bank_mask:0xf
  v_and_b32_dpp v107, v6, v11 row_newbcast:8 row_mask:0xf bank_mask:0xf
  v_and_b32_dpp v108, v6, v8 row_newbcast:12 row_mask:0xf bank_mask:0xf
  v_and_b32_dpp v109, v6, v9 row_newbcast:12 row_mask:0xf bank_mask:0xf
  v_and_b32_dpp v110, v6, v10 row_newbcast:12 row_mask:0xf bank_mask:0xf
  v_and_b32_dpp v111, v6, v11 row_newbcast:12 row_mask:0xf bank_mask:0xf
  s_waitcnt vmcnt(9)
  v_mfma_f32_16x16x32_bf16 v[12:15], v[24:27], v[56:59], v[12:15]
  v_and_b32_dpp v112, v7, v8 row_newbcast:0 row_mask:0xf bank_mask:0xf
  v_and_b32_dpp v113, v7, v9 row_newbcast:0 row_mask:0xf bank_mask:0xf
  v_and_b32_dpp v114, v7, v10 row_newbcast:0 row_mask:0xf bank_mask:0xf
  v_and_b32_dpp v115, v7, v11 row_newbcast:0 row_mask:0xf bank_mask:0xf
  v_and_b32_dpp v116, v7, v8 row_newbcast:4 row_mask:0xf bank_mask:0xf
  v_and_b32_dpp v117, v7, v9 row_newbcast:4 row_mask:0xf bank_mask:0xf
  v_and_b32_dpp v118, v7, v10 row_newbcast:4 row_mask:0xf bank_mask:0xf
  v_and_b32_dpp v119, v7, v11 row_newbcast:4 row_mask:0xf bank_mask:0xf
  s_waitcnt vmcnt(8)
  v_mfma_f32_16x16x32_bf16 v[12:15], v[28:31], v[60:63], v[12:15]
  v_and_b32_dpp v120, v7, v8 row_newbcast:8 row_mask:0xf bank_mask:0xf
  v_and_b32_dpp v121, v7, v9 row_newbcast:8 row_mask:0xf bank_mask:0xf
  v_and_b32_dpp v122, v7, v10 row_newbcast:8 row_mask:0xf bank_mask:0xf
  v_and_b32_dpp v123, v7, v11 row_newbcast:8 row_mask:0xf bank_mask:0xf
  v_and_b32_dpp v124, v7, v8 row_newbcast:12 row_mask:0xf bank_mask:0xf
  v_and_b32_dpp v125, v7, v9 row_newbcast:12 row_mask:0xf bank_mask:0xf
  v_and_b32_dpp v126, v7, v10 row_newbcast:12 row_mask:0xf bank_mask:0xf
  v_and_b32_dpp v127, v7, v11 row_newbcast:12 row_mask:0xf bank_mask:0xf
  s_setprio 3
  s_lshl_b32 s11, s3, 2
  v_mov_b32 v17, s11
  v_and_b32 v18, 15, v0
  v_lshlrev_b32 v18, 3, v18
  v_lshrrev_b32 v19, 4, v0
  v_lshl_add_u32 v18, v19, 2, v18
  v_and_b32 v19, 7, v0
  v_lshlrev_b32 v19, 2, v19
  s_mov_b32 s42, 0x40000
LW_51:
  ds_read_b32 v16, v3 offset:16
  s_waitcnt lgkmcnt(0)
  v_readfirstlane_b32 s43, v16
  s_nop 1
  s_cmp_lt_u32 s43, 8
  s_cbranch_scc1 LR_53
LWD_52:
  ds_read_b32 v16, v17 offset:64
  ds_read_b32 v20, v19 offset:64
  ds_read_b64 v[26:27], v3 offset:40
  ds_read_b32 v28, v3 offset:12
  v_and_b32 v22, 1, v0
  v_lshlrev_b32 v22, 8, v22
  v_lshrrev_b32 v23, 1, v0
  v_lshl_add_u32 v22, v23, 2, v22
  v_lshlrev_b32 v23, 4, v0
  v_mov_b32 v21, 1
  s_lshl_b32 s15, s7, 10
  s_add_u32 s15, s15, 2621440
  s_add_u32 s12, s15, 262144
  s_waitcnt lgkmcnt(0)
  v_max_f32_dpp v20, v20, v20 row_ror:1 row_mask:0xf bank_mask:0xf
  s_nop 1
  v_max_f32_dpp v20, v20, v20 row_ror:2 row_mask:0xf bank_mask:0xf
  s_nop 1
  v_max_f32_dpp v20, v20, v20 row_ror:4 row_mask:0xf bank_mask:0xf
  v_readfirstlane_b32 s14, v28
  v_readfirstlane_b32 s76, v26
  v_readfirstlane_b32 s77, v27
  v_sub_f32 v16, v16, v20
  v_exp_f32 v16, v16
  s_waitcnt vmcnt(7)
  v_mfma_f32_16x16x32_bf16 v[12:15], v[96:99], v[64:67], v[12:15]
  s_waitcnt vmcnt(6)
  v_mfma_f32_16x16x32_bf16 v[12:15], v[100:103], v[68:71], v[12:15]
  s_waitcnt vmcnt(5)
  v_mfma_f32_16x16x32_bf16 v[12:15], v[104:107], v[72:75], v[12:15]
  s_waitcnt vmcnt(4)
  v_mfma_f32_16x16x32_bf16 v[12:15], v[108:111], v[76:79], v[12:15]
  s_waitcnt vmcnt(3)
  v_mfma_f32_16x16x32_bf16 v[12:15], v[112:115], v[80:83], v[12:15]
  s_waitcnt vmcnt(2)
  v_mfma_f32_16x16x32_bf16 v[12:15], v[116:119], v[84:87], v[12:15]
  s_waitcnt vmcnt(1)
  v_mfma_f32_16x16x32_bf16 v[12:15], v[120:123], v[88:91], v[12:15]
  s_waitcnt vmcnt(0)
  v_mfma_f32_16x16x32_bf16 v[12:15], v[124:127], v[92:95], v[12:15]
  s_mov_b64 exec, 0xffffffff
  s_nop 6
  v_mul_f32 v12, v16, v12
  v_mul_f32 v13, v16, v13
  v_mul_f32 v14, v16, v14
  v_mul_f32 v15, v16, v15
  ds_add_f32 v18, v12 offset:512
  ds_add_f32 v18, v13 offset:640
  ds_add_f32 v18, v14 offset:768
  ds_add_f32 v18, v15 offset:896
  s_mov_b64 exec, 1
  ds_add_rtn_u32 v21, v3, v21 offset:24
  s_mov_b64 exec, -1
  ds_read2_b32 v[24:25], v22 offset0:128 offset1:160
  s_waitcnt lgkmcnt(0)
  v_readfirstlane_b32 s11, v21
  s_nop 1
  s_cmp_lg_u32 s11, 7
  s_cbranch_scc1 L_nopub
  buffer_store_dwordx4 v[24:27], v23, s[44:47], s12 offen
  s_cmp_eq_u32 s14, 2
  s_cbranch_scc1 L_nopub
  buffer_store_dwordx4 v[24:27], v23, s[44:47], s15 offen sc1
L_nopub:
  s_cmp_ge_u32 s73, 160
  s_cbranch_scc1 L_end
  s_cmp_ge_u32 s3, 4
  s_cbranch_scc1 L_end
  s_and_b32 s15, s3, 1
  s_add_u32 s15, s15, 1
  s_lshr_b32 s72, s3, 1
  s_add_u32 s73, s73, s72
  s_setprio 3
  v_lshrrev_b32 v34, 3, v0
  v_lshlrev_b32 v34, 12, v34
  v_and_b32 v6, 7, v0
  v_lshl_add_u32 v34, v6, 4, v34
  v_lshrrev_b32 v35, 5, v0
  v_lshl_add_u32 v35, v6, 1, v35
  s_lshl_b32 s72, s72, 7
  v_lshl_add_u32 v33, v35, 3, s72
  v_lshlrev_b32 v35, 1, v35
  s_and_b32 s9, s73, 7
  s_bfe_u32 s11, s73, 0x20003
  s_lshr_b32 s10, s73, 5
  s_mul_i32 s14, s11, 1280
  s_lshl_b32 s12, s10, 8
  s_add_u32 s14, s14, s12
  s_lshl_b32 s12, s9, 5
  s_add_u32 s14, s14, s12
  s_lshl_b32 s64, s10, 18
  s_lshl_b32 s65, s11, 10
  s_add_u32 s64, s64, s65
  s_lshl_b32 s65, s9, 7
  s_add_u32 s64, s64, s65
  s_add_u32 s64, s64, 1048576
  s_sub_u32 s12, s15, 1
  s_lshl_b32 s12, s12, 17
  s_add_u32 s64, s64, s12
  s_add_u32 s65, s64, 32768
  s_add_u32 s66, s64, 65536
  s_add_u32 s67, s64, 98304
  s_mov_b32 s42, 0x40000
LW_54:
  ds_read_b32 v8, v3 offset:32
  s_waitcnt lgkmcnt(0)
  v_readfirstlane_b32 s43, v8
  s_nop 1
  s_cmp_lt_u32 s43, 1
  s_cbranch_scc1 LR_56
LWD_55:
  ds_read_b64 v[8:9], v3 offset:48
  v_mov_b32 v48, 0
  v_mov_b32 v49, 0
  s_mov_b32 s42, 0x40000
LW_57:
  ds_read_b32 v10, v3 offset:24
  s_waitcnt lgkmcnt(0)
  v_readfirstlane_b32 s43, v10
  s_nop 1
  s_cmp_lt_u32 s43, 8
  s_cbranch_scc1 LR_59
LWD_58:
  s_cmp_eq_u32 s15, 1
  s_cbranch_scc1 L_consA
  s_mov_b32 s42, 20000
  s_mov_b64 s[92:93], -1
  s_mov_b64 s[94:95], -1
  s_mov_b64 s[96:97], -1
  s_mov_b32 s98, 0xffffff
  s_mov_b32 s99, 0x0
G_60:
  s_mov_b64 exec, s[92:93]
  buffer_load_dwordx4 v[36:39], v34, s[44:47], s64 offen sc1
  s_mov_b64 exec, s[94:95]
  buffer_load_dwordx4 v[40:43], v34, s[44:47], s65 offen sc1
  s_mov_b64 exec, s[96:97]
  buffer_load_dwordx4 v[44:47], v34, s[44:47], s66 offen sc1
  s_mov_b64 exec, s[98:99]
  buffer_load_dwordx4 v[48:51], v34, s[44:47], s67 offen sc1
  s_waitcnt vmcnt(0)
GC_62:
  s_mov_b64 exec, s[92:93]
  v_cmp_ne_u64 s[92:93], s[76:77], v[38:39]
  s_mov_b64 exec, s[94:95]
  v_cmp_ne_u64 s[94:95], s[76:77], v[42:43]
  s_mov_b64 exec, s[96:97]
  v_cmp_ne_u64 s[96:97], s[76:77], v[46:47]
  s_mov_b64 exec, s[98:99]
  v_cmp_ne_u64 s[98:99], s[76:77], v[50:51]
  s_mov_b64 exec, -1
  s_or_b64 s[78:79], s[92:93], s[94:95]
  s_or_b64 s[78:79], s[78:79], s[96:97]
  s_or_b64 s[78:79], s[78:79], s[98:99]
  s_cbranch_scc1 GR_63
GD_61:
  v_pk_add_f32 v[36:37], v[36:37], v[40:41]
  v_pk_add_f32 v[44:45], v[44:45], v[48:49]
  v_pk_add_f32 v[36:37], v[36:37], v[44:45]
  s_nop 1
  v_permlane32_swap_b32 v36, v37
  v_add_f32 v36, v36, v37
  v_mov_b32 v37, v36
  s_nop 1
  v_permlane16_swap_b32 v36, v37
  v_add_f32 v36, v36, v37
  s_nop 1
  v_add_f32_dpp v36, v36, v36 row_ror:8 row_mask:0xf bank_mask:0xf
  v_cvt_pk_bf16_f32 v36, v36, v36
  v_lshlrev_b32 v36, 16, v36
  v_mul_f32 v36, v9, v36
  v_cvt_pk_bf16_f32 v37, v36, v36
  v_lshlrev_b32 v36, 16, v37
  v_mov_b32 v37, 1
  s_mov_b32 exec_lo, 0xff
  s_mov_b32 exec_hi, 0xff
  ds_write_b64 v33, v[36:37] offset:128
  s_branch L_end
L_consA:
  s_mov_b32 s42, 20000
  s_mov_b64 s[92:93], -1
  s_mov_b64 s[94:95], -1
  s_mov_b64 s[96:97], -1
  s_mov_b64 s[98:99], -1
G_64:
  s_mov_b64 exec, s[92:93]
  buffer_load_dwordx4 v[36:39], v34, s[44:47], s64 offen sc1
  s_mov_b64 exec, s[94:95]
  buffer_load_dwordx4 v[40:43], v34, s[44:47], s65 offen sc1
  s_mov_b64 exec, s[96:97]
  buffer_load_dwordx4 v[44:47], v34, s[44:47], s66 offen sc1
  s_mov_b64 exec, s[98:99]
  buffer_load_dwordx4 v[48:51], v34, s[44:47], s67 offen sc1
  s_waitcnt vmcnt(0)
GC_66:
  s_mov_b64 exec, s[92:93]
  v_cmp_ne_u64 s[92:93], s[76:77], v[38:39]
  s_mov_b64 exec, s[94:95]
  v_cmp_ne_u64 s[94:95], s[76:77], v[42:43]
  s_mov_b64 exec, s[96:97]
  v_cmp_ne_u64 s[96:97], s[76:77], v[46:47]
  s_mov_b64 exec, s[98:99]
  v_cmp_ne_u64 s[98:99], s[76:77], v[50:51]
  s_mov_b64 exec, -1
  s_or_b64 s[78:79], s[92:93], s[94:95]
  s_or_b64 s[78:79], s[78:79], s[96:97]
  s_or_b64 s[78:79], s[78:79], s[98:99]
  s_cbranch_scc1 GR_67
GD_65:
  ds_read_b64 v[10:11], v33 offset:128
  v_pk_add_f32 v[36:37], v[36:37], v[40:41]
  v_pk_add_f32 v[44:45], v[44:45], v[48:49]
  v_pk_add_f32 v[36:37], v[36:37], v[44:45]
  s_nop 1
  v_permlane32_swap_b32 v36, v37
  v_add_f32 v36, v36, v37
  v_mov_b32 v37, v36
  s_nop 1
  v_permlane16_swap_b32 v36, v37
  v_add_f32 v36, v36, v37
  s_nop 1
  v_add_f32_dpp v36, v36, v36 row_ror:8 row_mask:0xf bank_mask:0xf
  v_cvt_pk_bf16_f32 v36, v36, v36
  v_lshlrev_b32 v36, 16, v36
  v_mul_f32 v36, v8, v36
  v_cvt_pk_bf16_f32 v37, v36, v36
  v_lshlrev_b32 v36, 16, v37
  s_mov_b32 s42, 0x40000
BW_68:
  s_waitcnt lgkmcnt(0)
  v_cmp_ne_u32 vcc, 1, v11
  s_nop 1
  s_cmp_lg_u64 vcc, 0
  s_cbranch_scc1 BWR_70
BWD_69:
  v_add_f32 v32, v36, v10
  v_cvt_pk_bf16_f32 v32, v32, v32
  s_mov_b32 exec_lo, 0xff
  s_mov_b32 exec_hi, 0xff
  buffer_store_short v32, v35, s[56:59], s14 offen nt
  s_cmp_lg_u32 s73, 0
  s_cbranch_scc1 L_norst
  s_mov_b32 s68, s38
  s_and_b32 s69, s39, 0xffff
  s_mov_b32 s70, 256
  s_mov_b32 s71, 0x20000
  s_mov_b64 exec, 1
  v_mov_b32 v4, 0
  v_mov_b32 v5, 0
  buffer_store_dwordx2 v[4:5], v3, s[68:71], 0 offen
L_norst:
L_end:
  s_endpgm
BWL_71:
  ds_read_b64 v[10:11], v33 offset:128
  s_branch BW_68
LR_3:
  s_sleep 1
  s_sub_u32 s42, s42, 1
  s_cbranch_scc0 LW_1
  s_branch LWD_2
LR_6:
  s_sleep 1
  s_sub_u32 s42, s42, 1
  s_cbranch_scc0 LW_4
  s_branch LWD_5
LR_9:
  s_sleep 4
  s_sub_u32 s42, s42, 1
  s_cbranch_scc0 LW_7
  s_branch LWD_8
GR_17:
  s_sub_u32 s42, s42, 1
  s_cbranch_scc0 G_14
  s_branch GD_15
LR_20:
  s_sleep 4
  s_sub_u32 s42, s42, 1
  s_cbranch_scc0 LW_18
  s_branch LWD_19
LR_23:
  s_sleep 1
  s_sub_u32 s42, s42, 1
  s_cbranch_scc0 LW_21
  s_branch LWD_22
LR_26:
  s_sleep 4
  s_sub_u32 s42, s42, 1
  s_cbranch_scc0 LW_24
  s_branch LWD_25
GR_30:
  s_sub_u32 s42, s42, 1
  s_cbranch_scc0 G_27
  s_branch GD_28
LR_33:
  s_sleep 1
  s_sub_u32 s42, s42, 1
  s_cbranch_scc0 LW_31
  s_branch LWD_32
GR_37:
  s_sub_u32 s42, s42, 1
  s_cbranch_scc0 G_34
  s_branch GD_35
LR_40:
  s_sleep 4
  s_sub_u32 s42, s42, 1
  s_cbranch_scc0 LW_38
  s_branch LWD_39
GR_44:
  s_sub_u32 s42, s42, 1
  s_cbranch_scc0 G_41
  s_branch GD_42
LR_47:
  s_sub_u32 s42, s42, 1
  s_cbranch_scc0 LW_45
  s_branch LWD_46
LR_50:
  s_sleep 1
  s_sub_u32 s42, s42, 1
  s_cbranch_scc0 LW_48
  s_branch LWD_49
LR_53:
  s_sleep 1
  s_sub_u32 s42, s42, 1
  s_cbranch_scc0 LW_51
  s_branch LWD_52
LR_56:
  s_sleep 1
  s_sub_u32 s42, s42, 1
  s_cbranch_scc0 LW_54
  s_branch LWD_55
LR_59:
  s_sleep 1
  s_sub_u32 s42, s42, 1
  s_cbranch_scc0 LW_57
  s_branch LWD_58
GR_63:
  s_sub_u32 s42, s42, 1
  s_cbranch_scc0 G_60
  s_branch GD_61
GR_67:
  s_sub_u32 s42, s42, 1
  s_cbranch_scc0 G_64
  s_branch GD_65
BWR_70:
  s_sub_u32 s42, s42, 1
  s_cbranch_scc0 BWL_71
  s_branch BWD_69
.section .rodata,"a"
.p2align 6
.amdhsa_kernel gated_mix__sliding_block_cached__glu_gated_geglu__decode_kernel
  .amdhsa_next_free_vgpr 128
  .amdhsa_next_free_sgpr 102
  .amdhsa_accum_offset 128
  .amdhsa_group_segment_fixed_size 0
  .amdhsa_kernarg_size 104
  .amdhsa_user_sgpr_count 2
  .amdhsa_user_sgpr_kernarg_segment_ptr 1
  .amdhsa_system_sgpr_workgroup_id_x 1
  .amdhsa_float_denorm_mode_32 3
.end_amdhsa_kernel
```
